```python
import torch

def _softmax(x, axis=-1):
    return torch.softmax(x, dim=axis)
def _gelu(x):
    return torch.nn.functional.gelu(x, approximate="tanh")
def _silu(x):
    return torch.nn.functional.silu(x)
def _sigmoid(x):
    return torch.sigmoid(x)
def _layernorm(x, axis=-1, eps=1e-5):
    m = x.mean(dim=axis, keepdim=True)
    v = x.var(dim=axis, keepdim=True, unbiased=False)
    return (x - m) / torch.sqrt(v + eps)
def _scatter_add(tgt, idx, src, axis=0):
    return tgt.clone().index_add_(axis, idx, src)
def _segment_sum(src, seg, n):
    out = torch.zeros((n,) + src.shape[1:], dtype=src.dtype)
    return out.index_add_(0, seg, src)
def _pad(x, pw):
    flat = tuple(v for pair in reversed(pw) for v in pair)
    return torch.nn.functional.pad(x, flat)

kernel_name = 'recurrent_scan__sliding_block_cached__geglu_ffn__decode'

def setup_inputs():

    _w = (lambda a: (lambda t: t.to(torch.bfloat16) if t.is_floating_point() else t)(torch.as_tensor(a)))
    def _A_setup():
        B, Sq, D = 1, 1, 448
        Hq, Hkv, Sk, Dh = 16, 8, 32768, 256
        assert Hq % Hkv == 0, (Hq, Hkv)
        return {
            "x": _w((lambda *s: torch.randn(*s, dtype=torch.bfloat16) * 0.05)(B, Sq, D)),
            "k_cache": _w((lambda *s: torch.randn(*s, dtype=torch.bfloat16) * 1.6)(B, Hkv, Sk, Dh)),
            "v_cache": _w((lambda *s: torch.randn(*s, dtype=torch.bfloat16) * 0.2)(B, Hkv, Sk, Dh)),
            "wq": _w((lambda *s: torch.randn(*s, dtype=torch.bfloat16) * 1.6)(D, Hq * Dh) * (D ** -0.5)),
            "wo": _w((lambda *s: torch.randn(*s, dtype=torch.bfloat16) * 0.2)(Hq * Dh, D) * ((Hq * Dh) ** -0.5)),
        }
    _A_in = _A_setup()

    def _B_setup():
        B, S, D, F = 1, 1, 448, 1792
        return {
            "x": _w((lambda *s: torch.randn(*s, dtype=torch.bfloat16) * 0.05)(B, S, D)),
            "w_gate": _w((lambda *s: torch.randn(*s, dtype=torch.bfloat16) * 0.1)(D, F)),
            "w_up": _w((lambda *s: torch.randn(*s, dtype=torch.bfloat16) * 0.1)(D, F)),
            "w_down": _w((lambda *s: torch.randn(*s, dtype=torch.bfloat16) * 0.1)(F, D)),
        }
    _B_in = _B_setup()

    return {
        "A_x": _A_in["x"],
        "A_k_cache": _A_in["k_cache"],
        "A_v_cache": _A_in["v_cache"],
        "A_wq": _A_in["wq"],
        "A_wo": _A_in["wo"],
        "B_x": _B_in["x"],
        "B_w_gate": _B_in["w_gate"],
        "B_w_up": _B_in["w_up"],
        "B_w_down": _B_in["w_down"],
    }

def reference(A_x, A_k_cache, A_v_cache, A_wq, A_wo, B_x, B_w_gate, B_w_up, B_w_down):
    def _A_ref(x, k_cache, v_cache, wq, wo):
        B, Sq, D = x.shape
        Hq, Dh = 16, 256
        Hkv, Sk = k_cache.shape[1], k_cache.shape[2]
        W = min(4096, max(256, Sk // 4))
        rep = Hq // Hkv
        q = (lambda x, *d: x.permute(*d))((x @ wq).reshape(B, Sq, Hq, Dh), 0, 2, 1, 3)
        k = (lambda x, n, axis: torch.repeat_interleave(x, n, dim=axis))(k_cache[:, :, Sk - W:, :], rep, axis=1)
        v = (lambda x, n, axis: torch.repeat_interleave(x, n, dim=axis))(v_cache[:, :, Sk - W:, :], rep, axis=1)
        scores = torch.einsum("bhqd,bhkd->bhqk", q, k) * (Dh ** -0.5)
        p = _softmax(scores, axis=-1)
        o = torch.einsum("bhqk,bhkd->bhqd", p, v)
        return (lambda x, *d: x.permute(*d))(o, 0, 2, 1, 3).reshape(B, Sq, Hq * Dh) @ wo

    def _B_ref(x, w_gate, w_up, w_down):
        return (_gelu(x @ w_gate) * (x @ w_up)) @ w_down

    x = A_x
    xn = _layernorm(x, axis=-1)
    s = _A_ref(xn, A_k_cache, A_v_cache, A_wq, A_wo)
    g = _silu(_B_ref(xn, B_w_gate, B_w_up, B_w_down))
    return x + s * g
```

```asm
; @launch grid=(256,1,1) block=(768,1,1) lds=32768
.amdgcn_target "amdgcn-amd-amdhsa--gfx950"
.text
.globl recurrent_scan__sliding_block_cached__geglu_ffn__decode_kernel
.p2align 8
.type recurrent_scan__sliding_block_cached__geglu_ffn__decode_kernel,@function
recurrent_scan__sliding_block_cached__geglu_ffn__decode_kernel:
    s_load_dwordx16 s[4:19], s[0:1], 0
    s_load_dwordx8 s[20:27], s[0:1], 64
    v_readfirstlane_b32 s31, v0
    s_lshr_b32 s29, s2, 3
    s_and_b32 s28, s2, 7
    s_lshl_b32 s35, 1, 17
    s_lshr_b32 s3, s31, 6
    s_sub_u32 s48, s29, 8
    s_cbranch_scc1 L_w
    s_cmp_ge_u32 s48, 24
    s_cbranch_scc1 L_end
    s_cmp_lg_u32 s3, 11
    s_cbranch_scc1 L_att
    s_getpc_b64 s[88:89]
L_pcref:
    s_sub_u32 s50, s48, 11
    s_lshl_b32 s50, s50, 13
    v_lshl_add_u32 v8, v0, 7, s50
    v_min_u32 v8, L_end-L_pcref, v8
    global_load_dword v52, v8, s[88:89]
    s_branch L_att_helper
L_att:
    s_mul_i32 s49, s48, 10
    s_add_u32 s49, s49, s3
    s_add_u32 s50, s48, 240
    s_cmp_eq_u32 s3, 10
    s_cselect_b32 s49, s50, s49
    s_cmpk_ge_u32 s49, 256
    s_cbranch_scc1 L_att_idle
    s_lshl3_add_u32 s50, s28, 7
    s_lshl_b32 s50, s50, 8
    s_add_u32 s49, s49, s50
    s_lshl_b32 s49, s49, 5
    s_and_b32 s51, s3, 7
    s_add_u32 s49, s49, s51
    s_lshl_b32 s49, s49, 8
    v_and_b32 v9, 3, v0
    v_and_b32 v8, 0x30, v0
    v_lshlrev_b32 v9, 4, v9
    v_lshl_or_b32 v9, v8, 2, v9
    v_and_b32 v10, 12, v0
    v_lshl_or_b32 v10, v10, 9, v9
    s_lshl_b32 s34, 1, 27
    s_xor_b32 s52, s49, 256
    s_waitcnt lgkmcnt(0)
    s_mov_b64 s[32:33], s[6:7]
    buffer_load_dwordx4 v[16:19], v10, s[32:35], s49 offen nt
    buffer_load_dwordx4 v[20:23], v10, s[32:35], s52 offen nt
    s_barrier
    v_and_b32 v0, 63, v0
    v_and_b32 v1, 15, v0
    v_lshrrev_b32 v2, 4, v0
    s_movk_i32 s58, 0xfff
    s_mov_b32 s57, 1000000
    s_mov_b32 s36, s8
    s_mov_b32 s37, s9
    s_mov_b32 s38, 134217728
    s_mov_b32 s39, 0x20000
    s_mov_b32 s44, s26
    s_mov_b32 s45, s27
    s_mov_b32 s46, 536870912
    s_mov_b32 s47, 0x20000
    s_load_dword s30, s[26:27], 0
    s_waitcnt vmcnt(1)
    s_xor_b32 s52, s49, 512
    buffer_load_dwordx4 v[24:27], v10, s[32:35], s52 offen nt
    v_lshlrev_b32 v11, 11, v2
    v_lshl_add_u32 v11, v1, 4, v11
    v_lshrrev_b32 v8, 3, v1
    v_lshl_add_u32 v12, v8, 9, v9
    s_and_b32 s53, s49, 256
    v_xor_b32 v12, s53, v12
    v_xor_b32 v14, 256, v12
    v_lshlrev_b32 v15, 7, v8
    s_lshl_b32 s54, s3, 3
    s_add_u32 s54, s54, 1024
    v_add_u32 v15, s54, v15
    v_lshrrev_b32 v8, 1, v2
    v_lshlrev_b32 v13, 10, v8
    v_and_b32 v8, 1, v2
    v_lshl_add_u32 v13, v8, 8, v13
    v_lshl_add_u32 v13, v1, 4, v13
    s_lshl_b32 s54, s3, 11
    s_add_u32 s54, s54, 2048
    s_lshl_b32 s53, s53, 1
    s_add_u32 s54, s54, s53
    v_add_u32 v13, s54, v13
    v_xor_b32 v3, 512, v13
    v_and_b32 v8, 1, v1
    v_lshlrev_b32 v8, 4, v8
    v_mov_b32 v9, 0xffff
    v_lshlrev_b32 v9, v8, v9
    v_bfe_u32 v8, v1, 1, 2
    v_cmp_eq_u32 vcc, 0, v8
    s_nop 1
    v_cndmask_b32 v4, 0, v9, vcc
    v_cmp_eq_u32 vcc, 1, v8
    s_nop 1
    v_cndmask_b32 v5, 0, v9, vcc
    v_cmp_eq_u32 vcc, 2, v8
    s_nop 1
    v_cndmask_b32 v6, 0, v9, vcc
    v_cmp_eq_u32 vcc, 3, v8
    s_nop 1
    v_cndmask_b32 v7, 0, v9, vcc
    s_lshl_b32 s54, s3, 10
    v_lshlrev_b32 v128, 4, v0
    v_add_u32 v128, s54, v128
    s_lshl_b32 s53, s3, 6
    v_mov_b32 v129, s53
    v_lshrrev_b32 v130, 5, v0
    v_lshlrev_b32 v130, 9, v130
    v_lshl_add_u32 v130, v1, 5, v130
    v_and_b32 v131, 16, v0
    v_add3_u32 v130, v130, v131, s54
    s_mul_i32 s53, s28, 24
    s_add_u32 s53, s53, s48
    s_lshl_b32 s53, s53, 11
    s_add_u32 s53, s53, 262144
    s_add_u32 s54, s53, 1048576
    v_mov_b32 v131, 0xfff
    v_mov_b32 v8, 1536
    v_mov_b32 v9, 1
    s_mov_b32 s55, 0x3db8aa3b
    s_waitcnt vmcnt(1)
    s_xor_b32 s52, s49, 768
    buffer_load_dwordx4 v[28:31], v10, s[32:35], s52 offen nt
    s_waitcnt vmcnt(1)
    s_xor_b32 s52, s49, 1024
    buffer_load_dwordx4 v[32:35], v10, s[32:35], s52 offen nt
    s_waitcnt vmcnt(1)
    s_xor_b32 s52, s49, 1280
    buffer_load_dwordx4 v[36:39], v10, s[32:35], s52 offen nt
    s_waitcnt vmcnt(1)
    s_xor_b32 s52, s49, 1536
    buffer_load_dwordx4 v[40:43], v10, s[32:35], s52 offen nt
    s_waitcnt vmcnt(1)
    s_xor_b32 s52, s49, 1792
    buffer_load_dwordx4 v[44:47], v10, s[32:35], s52 offen nt
    s_waitcnt vmcnt(1)
    s_xor_b32 s52, s49, 0
    buffer_load_dwordx4 v[48:51], v11, s[36:39], s52 offen nt
    s_waitcnt vmcnt(1)
    s_xor_b32 s52, s49, 256
    buffer_load_dwordx4 v[52:55], v11, s[36:39], s52 offen nt
    s_mov_b32 s56, 9
    ds_read_b32 v80, v8
    s_waitcnt lgkmcnt(0)
    v_readfirstlane_b32 s60, v80
    s_cmp_lg_u32 s60, 0
    s_cbranch_scc1 L_qk
    s_waitcnt vmcnt(1)
    s_xor_b32 s52, s49, 512
    buffer_load_dwordx4 v[56:59], v11, s[36:39], s52 offen nt
    s_mov_b32 s56, 10
    ds_read_b32 v80, v8
    s_waitcnt lgkmcnt(0)
    v_readfirstlane_b32 s60, v80
    s_cmp_lg_u32 s60, 0
    s_cbranch_scc1 L_qk
    s_waitcnt vmcnt(1)
    s_xor_b32 s52, s49, 768
    buffer_load_dwordx4 v[60:63], v11, s[36:39], s52 offen nt
    s_mov_b32 s56, 11
    ds_read_b32 v80, v8
    s_waitcnt lgkmcnt(0)
    v_readfirstlane_b32 s60, v80
    s_cmp_lg_u32 s60, 0
    s_cbranch_scc1 L_qk
    s_waitcnt vmcnt(1)
    s_xor_b32 s52, s49, 1024
    buffer_load_dwordx4 v[64:67], v11, s[36:39], s52 offen nt
    s_mov_b32 s56, 12
    ds_read_b32 v80, v8
    s_waitcnt lgkmcnt(0)
    v_readfirstlane_b32 s60, v80
    s_cmp_lg_u32 s60, 0
    s_cbranch_scc1 L_qk
    s_waitcnt vmcnt(1)
    s_xor_b32 s52, s49, 1280
    buffer_load_dwordx4 v[68:71], v11, s[36:39], s52 offen nt
    s_mov_b32 s56, 13
    ds_read_b32 v80, v8
    s_waitcnt lgkmcnt(0)
    v_readfirstlane_b32 s60, v80
    s_cmp_lg_u32 s60, 0
    s_cbranch_scc1 L_qk
    s_waitcnt vmcnt(1)
    s_xor_b32 s52, s49, 1536
    buffer_load_dwordx4 v[72:75], v11, s[36:39], s52 offen nt
    s_mov_b32 s56, 14
    ds_read_b32 v80, v8
    s_waitcnt lgkmcnt(0)
    v_readfirstlane_b32 s60, v80
    s_cmp_lg_u32 s60, 0
    s_cbranch_scc1 L_qk
    s_waitcnt vmcnt(1)
    s_xor_b32 s52, s49, 1792
    buffer_load_dwordx4 v[76:79], v11, s[36:39], s52 offen nt
    s_mov_b32 s56, 15
    s_mov_b32 s61, 0
L_aq:
    ds_read_b32 v80, v8 offset:0
    s_add_u32 s61, s61, 1
    s_cmp_gt_u32 s61, s57
    s_cselect_b32 s62, -1, 0
    s_waitcnt lgkmcnt(0)
    v_readfirstlane_b32 s60, v80
    s_or_b32 s60, s60, s62
    s_cmp_lt_u32 s60, 1
    s_cbranch_scc1 L_aq
L_qk:
    ds_read_b128 v[80:83], v12
    ds_read_b128 v[84:87], v14
    s_add_u32 s30, s30, 0x10001
    s_lshr_b32 s31, s30, 16
    s_waitcnt vmcnt(2) lgkmcnt(0)
    v_mfma_f32_16x16x32_bf16 v[88:91], v[16:19], v[80:83], 0
    v_mfma_f32_16x16x32_bf16 v[92:95], v[24:27], v[80:83], 0
    v_mfma_f32_16x16x32_bf16 v[96:99], v[32:35], v[80:83], 0
    v_mfma_f32_16x16x32_bf16 v[100:103], v[40:43], v[80:83], 0
    v_mfma_f32_16x16x32_bf16 v[88:91], v[20:23], v[84:87], v[88:91]
    v_mfma_f32_16x16x32_bf16 v[92:95], v[28:31], v[84:87], v[92:95]
    v_mfma_f32_16x16x32_bf16 v[96:99], v[36:39], v[84:87], v[96:99]
    v_mfma_f32_16x16x32_bf16 v[100:103], v[44:47], v[84:87], v[100:103]
    s_nop 4
    v_mov_b32_dpp v16, v88 quad_perm:[0,0,0,0] row_mask:0xf bank_mask:0xf
    v_mov_b32_dpp v17, v92 quad_perm:[0,0,0,0] row_mask:0xf bank_mask:0xf
    v_mov_b32_dpp v18, v96 quad_perm:[0,0,0,0] row_mask:0xf bank_mask:0xf
    v_mov_b32_dpp v19, v100 quad_perm:[0,0,0,0] row_mask:0xf bank_mask:0xf
    v_add_f32_dpp v16, v89, v16 quad_perm:[1,1,1,1] row_mask:0xf bank_mask:0xf
    v_add_f32_dpp v17, v93, v17 quad_perm:[1,1,1,1] row_mask:0xf bank_mask:0xf
    v_add_f32_dpp v18, v97, v18 quad_perm:[1,1,1,1] row_mask:0xf bank_mask:0xf
    v_add_f32_dpp v19, v101, v19 quad_perm:[1,1,1,1] row_mask:0xf bank_mask:0xf
    v_add_f32_dpp v16, v90, v16 quad_perm:[2,2,2,2] row_mask:0xf bank_mask:0xf
    v_add_f32_dpp v17, v94, v17 quad_perm:[2,2,2,2] row_mask:0xf bank_mask:0xf
    v_add_f32_dpp v18, v98, v18 quad_perm:[2,2,2,2] row_mask:0xf bank_mask:0xf
    v_add_f32_dpp v19, v102, v19 quad_perm:[2,2,2,2] row_mask:0xf bank_mask:0xf
    v_add_f32_dpp v16, v91, v16 quad_perm:[3,3,3,3] row_mask:0xf bank_mask:0xf
    v_add_f32_dpp v17, v95, v17 quad_perm:[3,3,3,3] row_mask:0xf bank_mask:0xf
    v_add_f32_dpp v18, v99, v18 quad_perm:[3,3,3,3] row_mask:0xf bank_mask:0xf
    v_add_f32_dpp v19, v103, v19 quad_perm:[3,3,3,3] row_mask:0xf bank_mask:0xf
    v_cvt_pk_bf16_f32 v16, 0, v16
    v_cvt_pk_bf16_f32 v17, 0, v17
    v_cvt_pk_bf16_f32 v18, 0, v18
    v_cvt_pk_bf16_f32 v19, 0, v19
    v_max3_f32 v20, v16, v17, v18
    v_max_f32 v20, v20, v19
    v_mov_b32 v22, v20
    s_nop 1
    v_permlane16_swap_b32 v20, v22
    v_max_f32 v20, v20, v22
    v_mov_b32 v22, v20
    s_nop 1
    v_permlane32_swap_b32 v20, v22
    v_max_f32 v20, v20, v22
    v_sub_f32 v16, v16, v20
    v_sub_f32 v17, v17, v20
    v_sub_f32 v18, v18, v20
    v_sub_f32 v19, v19, v20
    v_mul_f32 v16, s55, v16
    v_mul_f32 v17, s55, v17
    v_mul_f32 v18, s55, v18
    v_mul_f32 v19, s55, v19
    v_exp_f32 v16, v16
    v_exp_f32 v17, v17
    v_exp_f32 v18, v18
    v_exp_f32 v19, v19
    v_add_f32 v21, v16, v17
    v_add_f32 v22, v18, v19
    v_add_f32 v21, v21, v22
    v_mov_b32 v22, v21
    s_nop 1
    v_permlane16_swap_b32 v21, v22
    v_add_f32 v21, v21, v22
    v_mov_b32 v22, v21
    s_nop 1
    v_permlane32_swap_b32 v21, v22
    v_add_f32 v21, v21, v22
    s_mov_b64 exec, 0x101
    ds_write_b64 v15, v[20:21]
    s_mov_b64 exec, 1
    ds_add_u32 v8, v9 offset:4
    s_mov_b64 exec, -1
    s_cmp_ge_u32 s56, 10
    s_cbranch_scc1 L_ld11
    s_waitcnt vmcnt(2)
    s_xor_b32 s52, s49, 512
    buffer_load_dwordx4 v[56:59], v11, s[36:39], s52 offen nt
L_ld11:
    s_cmp_ge_u32 s56, 11
    s_cbranch_scc1 L_ld12
    s_waitcnt vmcnt(2)
    s_xor_b32 s52, s49, 768
    buffer_load_dwordx4 v[60:63], v11, s[36:39], s52 offen nt
L_ld12:
    s_cmp_ge_u32 s56, 12
    s_cbranch_scc1 L_ld13
    s_waitcnt vmcnt(2)
    s_xor_b32 s52, s49, 1024
    buffer_load_dwordx4 v[64:67], v11, s[36:39], s52 offen nt
L_ld13:
    s_cmp_ge_u32 s56, 13
    s_cbranch_scc1 L_ld14
    s_waitcnt vmcnt(3)
    s_xor_b32 s52, s49, 1280
    buffer_load_dwordx4 v[68:71], v11, s[36:39], s52 offen nt
L_ld14:
    s_cmp_ge_u32 s56, 14
    s_cbranch_scc1 L_ld15
    s_waitcnt vmcnt(3)
    s_xor_b32 s52, s49, 1536
    buffer_load_dwordx4 v[72:75], v11, s[36:39], s52 offen nt
L_ld15:
    s_cmp_ge_u32 s56, 15
    s_cbranch_scc1 L_ld16
    s_xor_b32 s52, s49, 1792
    buffer_load_dwordx4 v[76:79], v11, s[36:39], s52 offen nt
L_ld16:
    s_mov_b64 exec, 1
    ds_add_u32 v8, v9 offset:8
    s_mov_b64 exec, -1
    v_cvt_pk_bf16_f32 v16, v16, v16
    v_cvt_pk_bf16_f32 v17, v17, v17
    v_cvt_pk_bf16_f32 v18, v18, v18
    v_cvt_pk_bf16_f32 v19, v19, v19
    v_and_b32 v104, v16, v4
    v_and_b32 v105, v16, v5
    v_and_b32 v106, v16, v6
    v_and_b32 v107, v16, v7
    v_and_b32 v108, v17, v4
    v_and_b32 v109, v17, v5
    v_and_b32 v110, v17, v6
    v_and_b32 v111, v17, v7
    v_and_b32 v112, v18, v4
    v_and_b32 v113, v18, v5
    v_and_b32 v114, v18, v6
    v_and_b32 v115, v18, v7
    v_and_b32 v116, v19, v4
    v_and_b32 v117, v19, v5
    v_and_b32 v118, v19, v6
    v_and_b32 v119, v19, v7
    s_waitcnt vmcnt(7)
    v_mfma_f32_16x16x32_bf16 v[120:123], v[104:107], v[48:51], 0
    s_waitcnt vmcnt(6)
    v_mfma_f32_16x16x32_bf16 v[124:127], v[104:107], v[52:55], 0
    s_waitcnt vmcnt(5)
    v_mfma_f32_16x16x32_bf16 v[120:123], v[108:111], v[56:59], v[120:123]
    s_waitcnt vmcnt(4)
    v_mfma_f32_16x16x32_bf16 v[124:127], v[108:111], v[60:63], v[124:127]
    s_waitcnt vmcnt(3)
    v_mfma_f32_16x16x32_bf16 v[120:123], v[112:115], v[64:67], v[120:123]
    s_waitcnt vmcnt(2)
    v_mfma_f32_16x16x32_bf16 v[124:127], v[112:115], v[68:71], v[124:127]
    s_waitcnt vmcnt(1)
    v_mfma_f32_16x16x32_bf16 v[120:123], v[116:119], v[72:75], v[120:123]
    s_waitcnt vmcnt(0)
    v_mfma_f32_16x16x32_bf16 v[124:127], v[116:119], v[76:79], v[124:127]
    s_nop 5
    ds_write_b128 v13, v[120:123]
    s_nop 0
    ds_write_b128 v3, v[124:127]
    s_cmp_ge_u32 s3, 2
    s_waitcnt lgkmcnt(0)
    s_barrier
    s_cbranch_scc1 L_end
    ds_read_b128 v[16:19], v129 offset:1280
    ds_read_b128 v[20:23], v129 offset:1296
    ds_read_b128 v[24:27], v129 offset:1312
    ds_read_b128 v[32:35], v128 offset:2048
    ds_read_b128 v[36:39], v128 offset:4096
    ds_read_b128 v[40:43], v128 offset:6144
    ds_read_b128 v[44:47], v128 offset:8192
    ds_read_b128 v[48:51], v128 offset:10240
    ds_read_b128 v[52:55], v128 offset:12288
    ds_read_b128 v[56:59], v128 offset:14336
    ds_read_b128 v[60:63], v128 offset:16384
    ds_read_b128 v[64:67], v128 offset:18432
    ds_read_b128 v[68:71], v128 offset:20480
    ds_read_b128 v[72:75], v128 offset:22528
    s_waitcnt lgkmcnt(10)
    v_pk_mul_f32 v[28:29], v[32:33], v[16:17] op_sel:[0,0] op_sel_hi:[1,0]
    v_pk_mul_f32 v[30:31], v[34:35], v[16:17] op_sel:[0,0] op_sel_hi:[1,0]
    s_waitcnt lgkmcnt(9)
    v_pk_fma_f32 v[28:29], v[36:37], v[16:17], v[28:29] op_sel:[0,1,0] op_sel_hi:[1,1,1]
    v_pk_fma_f32 v[30:31], v[38:39], v[16:17], v[30:31] op_sel:[0,1,0] op_sel_hi:[1,1,1]
    s_waitcnt lgkmcnt(8)
    v_pk_fma_f32 v[28:29], v[40:41], v[18:19], v[28:29] op_sel:[0,0,0] op_sel_hi:[1,0,1]
    v_pk_fma_f32 v[30:31], v[42:43], v[18:19], v[30:31] op_sel:[0,0,0] op_sel_hi:[1,0,1]
    s_waitcnt lgkmcnt(7)
    v_pk_fma_f32 v[28:29], v[44:45], v[18:19], v[28:29] op_sel:[0,1,0] op_sel_hi:[1,1,1]
    v_pk_fma_f32 v[30:31], v[46:47], v[18:19], v[30:31] op_sel:[0,1,0] op_sel_hi:[1,1,1]
    s_waitcnt lgkmcnt(6)
    v_pk_fma_f32 v[28:29], v[48:49], v[20:21], v[28:29] op_sel:[0,0,0] op_sel_hi:[1,0,1]
    v_pk_fma_f32 v[30:31], v[50:51], v[20:21], v[30:31] op_sel:[0,0,0] op_sel_hi:[1,0,1]
    s_waitcnt lgkmcnt(5)
    v_pk_fma_f32 v[28:29], v[52:53], v[20:21], v[28:29] op_sel:[0,1,0] op_sel_hi:[1,1,1]
    v_pk_fma_f32 v[30:31], v[54:55], v[20:21], v[30:31] op_sel:[0,1,0] op_sel_hi:[1,1,1]
    s_waitcnt lgkmcnt(4)
    v_pk_fma_f32 v[28:29], v[56:57], v[22:23], v[28:29] op_sel:[0,0,0] op_sel_hi:[1,0,1]
    v_pk_fma_f32 v[30:31], v[58:59], v[22:23], v[30:31] op_sel:[0,0,0] op_sel_hi:[1,0,1]
    s_waitcnt lgkmcnt(3)
    v_pk_fma_f32 v[28:29], v[60:61], v[22:23], v[28:29] op_sel:[0,1,0] op_sel_hi:[1,1,1]
    v_pk_fma_f32 v[30:31], v[62:63], v[22:23], v[30:31] op_sel:[0,1,0] op_sel_hi:[1,1,1]
    s_waitcnt lgkmcnt(2)
    v_pk_fma_f32 v[28:29], v[64:65], v[24:25], v[28:29] op_sel:[0,0,0] op_sel_hi:[1,0,1]
    v_pk_fma_f32 v[30:31], v[66:67], v[24:25], v[30:31] op_sel:[0,0,0] op_sel_hi:[1,0,1]
    s_waitcnt lgkmcnt(1)
    v_pk_fma_f32 v[28:29], v[68:69], v[24:25], v[28:29] op_sel:[0,1,0] op_sel_hi:[1,1,1]
    v_pk_fma_f32 v[30:31], v[70:71], v[24:25], v[30:31] op_sel:[0,1,0] op_sel_hi:[1,1,1]
    s_waitcnt lgkmcnt(0)
    v_pk_fma_f32 v[28:29], v[72:73], v[26:27], v[28:29] op_sel:[0,0,0] op_sel_hi:[1,0,1]
    v_pk_fma_f32 v[30:31], v[74:75], v[26:27], v[30:31] op_sel:[0,0,0] op_sel_hi:[1,0,1]
    v_bfi_b32 v28, v131, s30, v28
    v_bfi_b32 v29, v131, s30, v29
    v_bfi_b32 v30, v131, s31, v30
    v_bfi_b32 v31, v131, s31, v31
    buffer_store_dwordx4 v[28:31], v130, s[44:47], s53 offen
    buffer_store_dwordx4 v[28:31], v130, s[44:47], s54 offen sc1
L_b4:
    s_barrier
    s_endpgm
L_att_idle:
    v_and_b32 v0, 63, v0
    v_mov_b32 v16, 0
    v_mov_b32 v17, 0
    v_mov_b32 v18, 0
    v_mov_b32 v19, 0
    v_lshlrev_b32 v8, 4, v0
    ds_write_b128 v8, v[16:19] offset:22528
    ds_write_b128 v8, v[16:19] offset:23552
    v_and_b32 v8, 1, v0
    v_lshlrev_b32 v8, 7, v8
    v_mov_b32 v16, 0xff7f0000
    ds_write_b64 v8, v[16:17] offset:1104
    s_barrier
    v_mov_b32 v8, 1536
    v_mov_b32 v9, 1
    s_mov_b64 exec, 1
    ds_add_u32 v8, v9 offset:4
    ds_add_u32 v8, v9 offset:8
    s_waitcnt lgkmcnt(0)
    s_endpgm
.p2align 8
L_att_helper:
    v_and_b32 v0, 63, v0
    v_lshlrev_b32 v8, 4, v0
    v_mov_b32 v14, 1536
    v_mov_b32 v16, 0
    v_mov_b32 v17, 0
    ds_write_b64 v14, v[16:17]
    ds_write_b64 v14, v[16:17] offset:8
    s_waitcnt lgkmcnt(0)
    s_barrier
    v_and_b32 v1, 15, v0
    v_lshrrev_b32 v2, 4, v0
    s_movk_i32 s58, 0xfff
    s_mov_b32 s57, 1000000
    s_mov_b32 s44, s26
    s_mov_b32 s45, s27
    s_mov_b32 s46, 536870912
    s_mov_b32 s47, 0x20000
    s_load_dword s30, s[26:27], 0
    s_mul_i32 s56, s28, 24
    s_add_u32 s56, s56, s48
    s_lshl_b32 s56, s56, 11
    s_add_u32 s56, s56, 262144
    s_mov_b32 s59, 0xffff
    v_lshlrev_b32 v9, 3, v0
    s_lshl_b32 s53, s28, 11
    s_add_u32 s53, s53, 65536
    s_mov_b32 s54, 0x07060302
    v_mov_b32 v15, 1
    s_setprio 3
    s_waitcnt lgkmcnt(0)
    s_add_u32 s30, s30, 0x10001
    s_lshr_b32 s31, s30, 16
    s_mov_b32 s61, 0
    s_mov_b32 s60, s53
    s_add_u32 s62, s53, 1048576
L_pq:
    buffer_load_dwordx4 v[16:19], v8, s[44:47], s60 offen sc1
    buffer_load_dwordx4 v[20:23], v8, s[44:47], s60 offen offset:1024 sc1
    s_add_u32 s61, s61, 1
    s_and_b32 s63, s61, 15
    s_cmp_eq_u32 s63, 15
    s_cselect_b32 s60, s62, s53
    s_cmp_gt_u32 s61, s57
    s_cselect_b32 s63, 0, s59
    s_waitcnt vmcnt(0)
    v_bitop3_b32 v24, v16, v17, s30 bitop3:0x7e
    v_bitop3_b32 v25, v18, v19, s31 bitop3:0x7e
    v_bitop3_b32 v26, v20, v21, s30 bitop3:0x7e
    v_bitop3_b32 v27, v22, v23, s31 bitop3:0x7e
    v_or3_b32 v24, v24, v26, v27
    v_bitop3_b32 v24, v24, v25, s63 bitop3:0xa8
    v_cmp_ne_u32 vcc, 0, v24
    s_and_b64 exec, exec, vcc
    s_cbranch_execnz L_pq
    s_mov_b64 exec, -1
    v_perm_b32 v24, v17, v16, s54
    v_perm_b32 v25, v19, v18, s54
    v_perm_b32 v26, v21, v20, s54
    v_perm_b32 v27, v23, v22, s54
    ds_write_b64 v9, v[24:25] offset:0
    ds_write_b64 v9, v[26:27] offset:512
    ds_write_b32 v14, v15
    buffer_load_dwordx4 v[32:35], v8, s[44:47], s56 offen sc1
    buffer_load_dwordx4 v[36:39], v8, s[44:47], s56 offen offset:1024 sc1
    v_and_b32 v9, 0xf8, v9
    v_lshrrev_b32 v10, 1, v9
    v_and_b32 v12, 16, v0
    v_lshlrev_b32 v12, 5, v12
    s_lshl_b32 s53, s28, 10
    s_lshl_b32 s54, s48, 4
    s_add_u32 s53, s53, s54
    s_add_u32 s53, s53, 131072
    s_add_u32 s54, s53, 1048576
    s_mov_b32 s55, 0x3db8aa3b
    v_mov_b32 v11, 0xfff
    v_mov_b32 v13, 0xff7f0000
    v_cmp_gt_u32 vcc, 11, v1
    s_setprio 0
    s_mov_b32 s61, 0
L_hs:
    ds_read_b32 v24, v14 offset:4
    s_add_u32 s61, s61, 1
    s_cmp_gt_u32 s61, s57
    s_cselect_b32 s62, -1, 0
    s_waitcnt lgkmcnt(0)
    v_readfirstlane_b32 s60, v24
    s_or_b32 s60, s60, s62
    s_cmp_lt_u32 s60, 11
    s_cbranch_scc1 L_hs
    s_setprio 3
    ds_read_b64 v[40:41], v9 offset:1024
    s_waitcnt lgkmcnt(0)
    v_cndmask_b32 v40, v13, v40, vcc
    v_cndmask_b32 v41, 0, v41, vcc
    v_mov_b32 v44, v40
    s_nop 1
    v_max_f32_dpp v44, v44, v44 row_ror:8 row_mask:0xf bank_mask:0xf
    s_nop 1
    v_max_f32_dpp v44, v44, v44 row_ror:4 row_mask:0xf bank_mask:0xf
    s_nop 1
    v_max_f32_dpp v44, v44, v44 row_ror:2 row_mask:0xf bank_mask:0xf
    s_nop 1
    v_max_f32_dpp v44, v44, v44 row_ror:1 row_mask:0xf bank_mask:0xf
    v_sub_f32 v40, v40, v44
    v_mul_f32 v40, s55, v40
    v_exp_f32 v40, v40
    s_nop 0
    ds_write_b32 v10, v40 offset:1280
    v_mul_f32 v45, v40, v41
    s_nop 1
    v_add_f32_dpp v45, v45, v45 row_ror:8 row_mask:0xf bank_mask:0xf
    s_nop 1
    v_add_f32_dpp v45, v45, v45 row_ror:4 row_mask:0xf bank_mask:0xf
    s_nop 1
    v_add_f32_dpp v45, v45, v45 row_ror:2 row_mask:0xf bank_mask:0xf
    s_nop 1
    v_add_f32_dpp v45, v45, v45 row_ror:1 row_mask:0xf bank_mask:0xf
    v_bfi_b32 v44, v11, s30, v44
    v_bfi_b32 v45, v11, s30, v45
    v_mov_b32 v46, s31
    v_mov_b32 v47, s31
    s_mov_b64 exec, 0x10001
    buffer_store_dwordx4 v[44:47], v12, s[44:47], s53 offen
    buffer_store_dwordx4 v[44:47], v12, s[44:47], s54 offen sc1
    s_mov_b64 exec, -1
    s_setprio 0
    s_mov_b32 s40, s12
    s_mov_b32 s41, s13
    s_mul_i32 s84, s28, 458752
    s_add_u32 s42, s84, 458752
    s_mov_b32 s43, 0x20000
    s_mul_i32 s85, s48, 19456
    s_add_u32 s84, s84, s85
    s_mov_b32 s61, 0
L_hp:
    ds_read_b32 v24, v14 offset:8
    s_add_u32 s61, s61, 1
    s_cmp_gt_u32 s61, s57
    s_cselect_b32 s62, -1, 0
    s_waitcnt lgkmcnt(0)
    v_readfirstlane_b32 s60, v24
    s_or_b32 s60, s60, s62
    s_cmp_lt_u32 s60, 11
    s_cbranch_scc1 L_hp
    buffer_load_dwordx4 v[48:51], v8, s[40:43], s84 offen offset:0
    buffer_load_dwordx4 v[48:51], v8, s[40:43], s84 offen offset:1024
    buffer_load_dwordx4 v[48:51], v8, s[40:43], s84 offen offset:2048
    buffer_load_dwordx4 v[48:51], v8, s[40:43], s84 offen offset:3072
    s_add_u32 s84, s84, 4096
    s_min_u32 s84, s84, s42
    buffer_load_dwordx4 v[48:51], v8, s[40:43], s84 offen offset:0
    buffer_load_dwordx4 v[48:51], v8, s[40:43], s84 offen offset:1024
    buffer_load_dwordx4 v[48:51], v8, s[40:43], s84 offen offset:2048
    buffer_load_dwordx4 v[48:51], v8, s[40:43], s84 offen offset:3072
    s_add_u32 s84, s84, 4096
    s_min_u32 s84, s84, s42
    buffer_load_dwordx4 v[48:51], v8, s[40:43], s84 offen offset:0
    buffer_load_dwordx4 v[48:51], v8, s[40:43], s84 offen offset:1024
    buffer_load_dwordx4 v[48:51], v8, s[40:43], s84 offen offset:2048
    buffer_load_dwordx4 v[48:51], v8, s[40:43], s84 offen offset:3072
    s_add_u32 s84, s84, 4096
    s_min_u32 s84, s84, s42
    buffer_load_dwordx4 v[48:51], v8, s[40:43], s84 offen offset:0
    buffer_load_dwordx4 v[48:51], v8, s[40:43], s84 offen offset:1024
    buffer_load_dwordx4 v[48:51], v8, s[40:43], s84 offen offset:2048
    buffer_load_dwordx4 v[48:51], v8, s[40:43], s84 offen offset:3072
    s_add_u32 s84, s84, 4096
    s_min_u32 s84, s84, s42
    buffer_load_dwordx4 v[48:51], v8, s[40:43], s84 offen offset:0
    buffer_load_dwordx4 v[48:51], v8, s[40:43], s84 offen offset:1024
    buffer_load_dwordx4 v[48:51], v8, s[40:43], s84 offen offset:2048
    s_mov_b32 s32, s4
    s_mov_b32 s33, s5
    s_mov_b32 s34, 896
    s_mov_b32 s35, 0x20000
    s_mov_b32 s36, s22
    s_mov_b32 s37, s23
    s_mov_b32 s38, 896
    s_mov_b32 s39, 0x20000
    s_lshl_b32 s50, s28, 4
    s_add_u32 s50, s50, s48
    s_sub_u32 s50, s50, 8
    s_lshl_b32 s49, s50, 3
    v_lshlrev_b32 v8, 1, v2
    v_mul_u32_u24 v16, 1792, v0
    v_min_u32 v17, 55, v0
    v_mul_u32_u24 v17, 1792, v17
    v_cmp_gt_u32 s[52:53], 56, v0
    s_lshl_b32 s51, s50, 4
    s_add_u32 s51, s51, 655360
    s_add_u32 s55, s51, 114688
    v_mov_b32 v3, 0xfff
    s_movk_i32 s54, 0x800
    s_mov_b32 s56, 0xbfb8aa3b
    s_barrier
    s_cmp_lt_u32 s48, 8
    s_cbranch_scc1 L_end
    s_cmp_ge_u32 s28, 7
    s_cbranch_scc1 L_end
    s_barrier
    buffer_load_ushort v10, v8, s[32:35], s49 offen
    buffer_load_dwordx4 v[24:27], v16, s[44:47], s51 offen sc1
    s_mov_b32 s61, 0
    s_mov_b32 s60, s55
L_pf:
    buffer_load_dwordx4 v[20:23], v17, s[44:47], s60 offen sc1
    s_add_u32 s61, s61, 1
    s_cmp_gt_u32 s61, s57
    s_cselect_b32 s63, 0, s58
    s_waitcnt vmcnt(0)
    v_bitop3_b32 v28, v20, v21, s30 bitop3:0x7e
    v_bitop3_b32 v29, v22, v23, s31 bitop3:0x7e
    v_bitop3_b32 v28, v28, v29, s63 bitop3:0xa8
    v_cmp_ne_u32 vcc, 0, v28
    s_and_b64 exec, exec, vcc
    s_cbranch_execnz L_pf
    s_mov_b64 exec, -1
    v_bfi_b32 v20, v3, s54, v20
    v_bfi_b32 v21, v3, s54, v21
    v_bfi_b32 v22, v3, s54, v22
    v_bfi_b32 v23, v3, s54, v23
    v_cndmask_b32 v32, 0, v20, s[52:53]
    v_cndmask_b32 v33, 0, v21, s[52:53]
    v_cndmask_b32 v34, 0, v22, s[52:53]
    v_cndmask_b32 v35, 0, v23, s[52:53]
    s_nop 0
    v_permlane32_swap_b32 v32, v34
    v_permlane32_swap_b32 v33, v35
    v_add_f32 v32, v32, v34
    v_add_f32 v33, v33, v35
    s_nop 1
    v_permlane16_swap_b32 v32, v33
    v_add_f32 v32, v32, v33
    s_nop 1
    v_add_f32_dpp v32, v32, v32 row_ror:8 row_mask:0xf bank_mask:0xf
    s_nop 1
    v_add_f32_dpp v32, v32, v32 row_ror:4 row_mask:0xf bank_mask:0xf
    s_nop 1
    v_add_f32_dpp v32, v32, v32 row_ror:2 row_mask:0xf bank_mask:0xf
    s_nop 1
    v_add_f32_dpp v32, v32, v32 row_ror:1 row_mask:0xf bank_mask:0xf
    v_cvt_pk_bf16_f32 v32, 0, v32
    v_mul_f32 v36, s56, v32
    v_exp_f32 v36, v36
    s_nop 0
    v_add_f32 v36, 1.0, v36
    v_rcp_f32 v36, v36
    s_nop 0
    v_mul_f32 v32, v32, v36
    v_cvt_pk_bf16_f32 v32, 0, v32
    v_lshlrev_b32 v12, 16, v10
    v_mov_b32 v9, s30
    v_mov_b32 v13, 0
    s_mov_b32 s61, 0
    s_mov_b32 s60, s51
L_pa:
    buffer_load_dwordx4 v[20:23], v16, s[44:47], s60 offen sc1
    s_add_u32 s61, s61, 1
    s_cmp_gt_u32 s61, s57
    s_cselect_b32 s63, 0, s58
    s_waitcnt vmcnt(0)
    v_bitop3_b32 v28, v20, v21, s30 bitop3:0x7e
    v_bitop3_b32 v29, v22, v23, s31 bitop3:0x7e
    v_bitop3_b32 v28, v28, v29, s63 bitop3:0xa8
    v_cmp_ne_u32 vcc, 0, v28
    s_and_b64 exec, exec, vcc
    s_cbranch_execnz L_pa
    s_mov_b64 exec, -1
    v_bfi_b32 v20, v3, s54, v20
    v_bfi_b32 v21, v3, s54, v21
    v_bfi_b32 v22, v3, s54, v22
    v_bfi_b32 v23, v3, s54, v23
    s_nop 0
    v_permlane32_swap_b32 v20, v22
    v_permlane32_swap_b32 v21, v23
    v_add_f32 v20, v20, v22
    v_add_f32 v21, v21, v23
    s_nop 1
    v_permlane16_swap_b32 v20, v21
    v_add_f32 v20, v20, v21
    s_nop 1
    v_add_f32_dpp v20, v20, v20 row_ror:8 row_mask:0xf bank_mask:0xf
    s_nop 1
    v_add_f32_dpp v20, v20, v20 row_ror:4 row_mask:0xf bank_mask:0xf
    s_nop 1
    v_add_f32_dpp v20, v20, v20 row_ror:2 row_mask:0xf bank_mask:0xf
    s_nop 1
    v_add_f32_dpp v20, v20, v20 row_ror:1 row_mask:0xf bank_mask:0xf
    v_cvt_pk_bf16_f32 v20, 0, v20
    v_mul_f32 v20, v20, v32
    v_cvt_pk_bf16_f32 v20, 0, v20
    v_add_f32 v20, v20, v12
    v_cvt_pk_bf16_f32 v20, v20, v20
    s_mov_b32 exec_lo, 0x10001
    s_mov_b32 exec_hi, 0x10001
    buffer_store_short v20, v8, s[36:39], s49 offen
    s_cmp_lg_u32 s50, 0
    s_cbranch_scc1 L_nobump
    s_mov_b64 exec, 1
    buffer_store_dword v9, v13, s[44:47], 0 offen offset:0
L_nobump:
    s_endpgm
.p2align 8
L_w:
    v_and_b32 v0, 63, v0
    s_lshl3_add_u32 s48, s28, s29
    s_cmp_lg_u32 s3, 0
    s_cbranch_scc1 L_w_nx
    s_setprio 3
    v_lshlrev_b32 v8, 4, v0
    s_movk_i32 s34, 896
    s_waitcnt lgkmcnt(0)
    s_mov_b64 s[32:33], s[4:5]
    buffer_load_dwordx4 v[16:19], v8, s[32:35], 0 offen
    s_branch L_ln
L_w_nx:
    s_cmp_gt_u32 s3, 8
    s_cbranch_scc1 L_g9
    s_and_b32 s3, s3, 7
    v_and_b32 v9, 7, v0
    v_lshlrev_b32 v9, 4, v9
    v_and_b32 v8, 8, v0
    v_and_b32 v10, 0x30, v0
    v_lshl_or_b32 v10, v8, 3, v10
    v_lshl_or_b32 v11, v10, 12, v9
    s_lshl_b32 s50, s3, 19
    s_lshl_b32 s51, s48, 7
    s_add_u32 s50, s50, s51
    s_mov_b32 s34, 3670016
    s_cmp_eq_u32 s3, 7
    s_waitcnt lgkmcnt(0)
    s_mov_b64 s[32:33], s[10:11]
    s_cbranch_scc1 L_w_pro
    buffer_load_dwordx4 v[32:35], v11, s[32:35], s50 offen nt
    s_addk_i32 s50, 8192
    buffer_load_dwordx4 v[36:39], v11, s[32:35], s50 offen nt
    s_addk_i32 s50, 8192
    buffer_load_dwordx4 v[40:43], v11, s[32:35], s50 offen nt
    s_addk_i32 s50, 8192
    buffer_load_dwordx4 v[44:47], v11, s[32:35], s50 offen nt
    s_addk_i32 s50, 8192
    buffer_load_dwordx4 v[48:51], v11, s[32:35], s50 offen nt
    s_addk_i32 s50, 8192
    buffer_load_dwordx4 v[52:55], v11, s[32:35], s50 offen nt
    s_addk_i32 s50, 8192
    buffer_load_dwordx4 v[56:59], v11, s[32:35], s50 offen nt
    s_addk_i32 s50, 8192
    buffer_load_dwordx4 v[60:63], v11, s[32:35], s50 offen nt
L_w_pro:
    v_and_b32 v1, 15, v0
    v_lshrrev_b32 v2, 4, v0
    s_movk_i32 s58, 0xfff
    s_mov_b32 s57, 1000000
    s_mov_b32 s44, s26
    s_mov_b32 s45, s27
    s_mov_b32 s46, 536870912
    s_mov_b32 s47, 0x20000
    s_load_dword s30, s[26:27], 0
    s_mov_b32 s36, s12
    s_mov_b32 s37, s13
    s_mov_b32 s38, 3670016
    s_mov_b32 s39, 0x20000
    s_mov_b32 s40, s20
    s_mov_b32 s41, s21
    s_mov_b32 s42, 1605632
    s_mov_b32 s43, 0x20000
    s_mov_b32 s88, s16
    s_mov_b32 s89, s17
    s_mov_b32 s90, 1605632
    s_mov_b32 s91, 0x20000
    s_mov_b32 s92, s18
    s_mov_b32 s93, s19
    s_mov_b32 s94, 1605632
    s_mov_b32 s95, 0x20000
    s_mul_i32 s49, s28, 7
    s_add_u32 s49, s49, s29
    s_cmp_gt_u32 s29, 3
    s_subb_u32 s49, s49, 0
    s_cmp_lg_u32 s29, 3
    s_cselect_b32 s56, 1, 0
    v_lshrrev_b32 v8, 3, v8
    v_mul_u32_u24 v12, 896, v10
    v_add_u32 v12, v12, v9
    v_mul_u32_u24 v13, 224, v10
    v_lshl_add_u32 v14, v13, 1, v9
    v_add_u32 v13, v13, v9
    s_and_b32 s51, s49, 1
    s_mul_i32 s51, s51, 7
    s_add_u32 s51, s51, s3
    s_mul_i32 s82, s51, 114688
    s_lshr_b32 s52, s49, 1
    s_lshl_b32 s52, s52, 7
    s_add_u32 s82, s82, s52
    s_add_u32 s83, s82, 7168
    s_lshl_b32 s51, s51, 7
    v_add_u32 v156, s51, v10
    s_lshl_b32 s51, s3, 8
    v_lshl_add_u32 v157, v10, 1, s51
    s_lshl_b32 s51, s3, 7
    s_mul_i32 s80, s48, 57344
    s_add_u32 s80, s80, s51
    s_add_u32 s96, s80, 3584
    s_mul_i32 s81, s49, 28672
    s_add_u32 s81, s81, s51
    v_and_b32 v15, 1, v2
    v_lshl_add_u32 v15, v15, 7, v9
    s_lshl_b32 s51, s3, 9
    v_lshl_add_u32 v158, v8, 8, v15
    v_add_u32 v158, s51, v158
    s_lshl_b32 s51, s3, 10
    v_lshl_add_u32 v15, v8, 9, v15
    v_add_u32 v15, s51, v15
    v_lshlrev_b32 v3, 1, v9
    v_lshl_add_u32 v159, v8, 4, v3
    v_and_b32 v8, 1, v1
    v_lshlrev_b32 v8, 4, v8
    v_mov_b32 v9, 0xffff
    v_lshlrev_b32 v9, v8, v9
    v_bfe_u32 v8, v1, 1, 2
    v_cmp_eq_u32 vcc, 0, v8
    s_nop 1
    v_cndmask_b32 v4, 0, v9, vcc
    v_cmp_eq_u32 vcc, 1, v8
    s_nop 1
    v_cndmask_b32 v5, 0, v9, vcc
    v_cmp_eq_u32 vcc, 2, v8
    s_nop 1
    v_cndmask_b32 v6, 0, v9, vcc
    v_cmp_eq_u32 vcc, 3, v8
    s_nop 1
    v_cndmask_b32 v7, 0, v9, vcc
    s_waitcnt lgkmcnt(0)
    s_add_u32 s30, s30, 0x10001
    s_lshr_b32 s31, s30, 16
    s_barrier
    s_cmp_eq_u32 s3, 7
    s_cbranch_scc1 L_w7
    ds_read_b128 v[16:19], v157 offset:0
    ds_read_b128 v[20:23], v157 offset:16
    ds_read_b128 v[144:147], v156 offset:0
    v_mov_b32 v8, 1
    v_mov_b32 v9, 2048
    s_cmp_eq_u32 s56, 0
    s_cselect_b32 s90, 0, s90
    s_cselect_b32 s94, 0, s94
    s_cselect_b32 s82, 0, s82
    s_cselect_b32 s83, 0, s83
    s_waitcnt lgkmcnt(0)
    v_and_b32 v24, v16, v4
    v_and_b32 v25, v16, v5
    v_and_b32 v26, v16, v6
    v_and_b32 v27, v16, v7
    s_waitcnt vmcnt(7)
    s_nop 0
    v_mfma_f32_16x16x32_bf16 v[148:151], v[24:27], v[32:35], 0
    v_and_b32 v28, v17, v4
    v_and_b32 v29, v17, v5
    v_and_b32 v30, v17, v6
    v_and_b32 v31, v17, v7
    s_waitcnt vmcnt(6)
    s_nop 0
    v_mfma_f32_16x16x32_bf16 v[148:151], v[28:31], v[36:39], v[148:151]
    v_and_b32 v24, v18, v4
    v_and_b32 v25, v18, v5
    v_and_b32 v26, v18, v6
    v_and_b32 v27, v18, v7
    s_waitcnt vmcnt(5)
    s_nop 0
    v_mfma_f32_16x16x32_bf16 v[148:151], v[24:27], v[40:43], v[148:151]
    v_and_b32 v28, v19, v4
    v_and_b32 v29, v19, v5
    v_and_b32 v30, v19, v6
    v_and_b32 v31, v19, v7
    s_waitcnt vmcnt(4)
    s_nop 0
    v_mfma_f32_16x16x32_bf16 v[148:151], v[28:31], v[44:47], v[148:151]
    v_and_b32 v24, v20, v4
    v_and_b32 v25, v20, v5
    v_and_b32 v26, v20, v6
    v_and_b32 v27, v20, v7
    s_waitcnt vmcnt(3)
    s_nop 0
    v_mfma_f32_16x16x32_bf16 v[148:151], v[24:27], v[48:51], v[148:151]
    v_and_b32 v28, v21, v4
    v_and_b32 v29, v21, v5
    v_and_b32 v30, v21, v6
    v_and_b32 v31, v21, v7
    s_waitcnt vmcnt(2)
    s_nop 0
    v_mfma_f32_16x16x32_bf16 v[148:151], v[28:31], v[52:55], v[148:151]
    buffer_load_dwordx4 v[64:67], v12, s[88:91], s82 offen nt
    v_and_b32 v24, v22, v4
    v_and_b32 v25, v22, v5
    v_and_b32 v26, v22, v6
    v_and_b32 v27, v22, v7
    s_waitcnt vmcnt(2)
    s_nop 0
    v_mfma_f32_16x16x32_bf16 v[148:151], v[24:27], v[56:59], v[148:151]
    buffer_load_dwordx4 v[68:71], v12, s[92:95], s82 offen nt
    v_and_b32 v28, v23, v4
    v_and_b32 v29, v23, v5
    v_and_b32 v30, v23, v6
    v_and_b32 v31, v23, v7
    s_waitcnt vmcnt(2)
    s_nop 0
    v_mfma_f32_16x16x32_bf16 v[148:151], v[28:31], v[60:63], v[148:151]
    buffer_load_dwordx4 v[72:75], v12, s[88:91], s82 offen offset:3584 nt
    s_mov_b32 exec_lo, 0xff00ff
    s_mov_b32 exec_hi, 0xff00ff00
    s_nop 4
    ds_write_b128 v158, v[148:151] offset:4096
    s_mov_b64 exec, 1
    ds_add_u32 v9, v8
    s_mov_b64 exec, -1
    s_cmp_eq_u32 s56, 0
    s_cbranch_scc1 L_w_def
    v_and_b32 v24, v144, v4
    v_and_b32 v25, v144, v5
    v_and_b32 v26, v144, v6
    v_and_b32 v27, v144, v7
    s_waitcnt vmcnt(2)
    s_nop 0
    v_mfma_f32_16x16x32_bf16 v[148:151], v[24:27], v[64:67], 0
    buffer_load_dwordx4 v[76:79], v12, s[92:95], s82 offen offset:3584 nt
    buffer_load_dwordx4 v[80:83], v12, s[88:91], s83 offen nt
    buffer_load_dwordx4 v[84:87], v12, s[92:95], s83 offen nt
    s_waitcnt vmcnt(4)
    v_mfma_f32_16x16x32_bf16 v[152:155], v[24:27], v[68:71], 0
    buffer_load_dwordx4 v[88:91], v12, s[88:91], s83 offen offset:3584 nt
    v_and_b32 v28, v145, v4
    v_and_b32 v29, v145, v5
    v_and_b32 v30, v145, v6
    v_and_b32 v31, v145, v7
    s_waitcnt vmcnt(4)
    s_nop 0
    v_mfma_f32_16x16x32_bf16 v[148:151], v[28:31], v[72:75], v[148:151]
    buffer_load_dwordx4 v[92:95], v12, s[92:95], s83 offen offset:3584 nt
    s_waitcnt vmcnt(4)
    v_mfma_f32_16x16x32_bf16 v[152:155], v[28:31], v[76:79], v[152:155]
    buffer_load_dwordx4 v[96:99], v13, s[40:43], s81 offen offset:0 nt
    v_and_b32 v24, v146, v4
    v_and_b32 v25, v146, v5
    v_and_b32 v26, v146, v6
    v_and_b32 v27, v146, v7
    s_waitcnt vmcnt(4)
    s_nop 0
    v_mfma_f32_16x16x32_bf16 v[148:151], v[24:27], v[80:83], v[148:151]
    buffer_load_dwordx4 v[100:103], v13, s[40:43], s81 offen offset:896 nt
    s_waitcnt vmcnt(4)
    v_mfma_f32_16x16x32_bf16 v[152:155], v[24:27], v[84:87], v[152:155]
    buffer_load_dwordx4 v[104:107], v13, s[40:43], s81 offen offset:1792 nt
    v_and_b32 v28, v147, v4
    v_and_b32 v29, v147, v5
    v_and_b32 v30, v147, v6
    v_and_b32 v31, v147, v7
    s_waitcnt vmcnt(4)
    s_nop 0
    v_mfma_f32_16x16x32_bf16 v[148:151], v[28:31], v[88:91], v[148:151]
    buffer_load_dwordx4 v[108:111], v13, s[40:43], s81 offen offset:2688 nt
    s_waitcnt vmcnt(4)
    v_mfma_f32_16x16x32_bf16 v[152:155], v[28:31], v[92:95], v[152:155]
    s_mov_b32 exec_lo, 0xff00ff
    s_mov_b32 exec_hi, 0xff00ff00
    s_nop 2
    ds_write_b128 v15, v[148:151] offset:8192
    s_nop 1
    ds_write_b128 v15, v[152:155] offset:8448
    s_mov_b64 exec, 1
    ds_add_u32 v9, v8 offset:4
    s_mov_b64 exec, -1
    s_mov_b32 s61, 0
L_wh:
    ds_read_b32 v16, v9 offset:8
    s_add_u32 s61, s61, 1
    s_cmp_gt_u32 s61, s57
    s_cselect_b32 s62, -1, 0
    s_waitcnt lgkmcnt(0)
    v_readfirstlane_b32 s60, v16
    s_or_b32 s60, s60, s62
    s_cmp_lt_u32 s60, 1
    s_cbranch_scc1 L_wh
    ds_read_b128 v[16:19], v10 offset:1792
    s_mul_i32 s52, s49, 1792
    s_lshl_b32 s51, s3, 8
    s_add_u32 s52, s52, s51
    s_add_u32 s52, s52, 770048
    v_mov_b32 v3, 0xfff
    v_and_b32 v20, 7, v0
    v_lshlrev_b32 v20, 5, v20
    v_and_b32 v21, 16, v0
    v_add_u32 v20, v20, v21
    s_waitcnt lgkmcnt(0)
    v_and_b32 v24, v16, v4
    v_and_b32 v25, v16, v5
    v_and_b32 v26, v16, v6
    v_and_b32 v27, v16, v7
    s_waitcnt vmcnt(3)
    s_nop 0
    v_mfma_f32_16x16x32_bf16 v[148:151], v[24:27], v[96:99], 0
    v_and_b32 v28, v17, v4
    v_and_b32 v29, v17, v5
    v_and_b32 v30, v17, v6
    v_and_b32 v31, v17, v7
    s_waitcnt vmcnt(2)
    s_nop 0
    v_mfma_f32_16x16x32_bf16 v[148:151], v[28:31], v[100:103], v[148:151]
    v_and_b32 v24, v18, v4
    v_and_b32 v25, v18, v5
    v_and_b32 v26, v18, v6
    v_and_b32 v27, v18, v7
    s_waitcnt vmcnt(1)
    s_nop 0
    v_mfma_f32_16x16x32_bf16 v[148:151], v[24:27], v[104:107], v[148:151]
    v_and_b32 v28, v19, v4
    v_and_b32 v29, v19, v5
    v_and_b32 v30, v19, v6
    v_and_b32 v31, v19, v7
    s_waitcnt vmcnt(0)
    s_nop 0
    v_mfma_f32_16x16x32_bf16 v[148:151], v[28:31], v[108:111], v[148:151]
    s_nop 7
    v_mov_b32 v24, v148
    v_mov_b32 v25, v149
    v_mov_b32 v26, v150
    v_mov_b32 v27, v151
    v_permlane32_swap_b32 v148, v24
    v_permlane32_swap_b32 v149, v25
    v_permlane32_swap_b32 v150, v26
    v_permlane32_swap_b32 v151, v27
    v_add_f32_dpp v148, v24, v148 row_ror:8 row_mask:0xf bank_mask:0xf
    v_add_f32_dpp v149, v25, v149 row_ror:8 row_mask:0xf bank_mask:0xf
    v_add_f32_dpp v150, v26, v150 row_ror:8 row_mask:0xf bank_mask:0xf
    v_add_f32_dpp v151, v27, v151 row_ror:8 row_mask:0xf bank_mask:0xf
    v_bfi_b32 v148, v3, s30, v148
    v_bfi_b32 v149, v3, s30, v149
    v_bfi_b32 v150, v3, s31, v150
    v_bfi_b32 v151, v3, s31, v151
    s_mov_b64 exec, 0x00ff00ff
    buffer_store_dwordx4 v[148:151], v20, s[44:47], s52 offen sc1
    s_mov_b64 exec, -1
L_w_def:
    v_mov_b32 v3, 0xfff
    v_and_b32 v17, 1, v0
    v_lshlrev_b32 v17, 6, v17
    v_lshl_add_u32 v17, v2, 4, v17
    s_mul_i32 s54, s48, 1792
    s_lshl_b32 s51, s3, 8
    s_add_u32 s54, s54, s51
    s_add_u32 s54, s54, 655360
    s_mov_b32 s52, 0x05040100
    s_mov_b32 s53, 0x07060302
    s_mov_b32 s61, 0
L_wt:
    ds_read_b32 v16, v9 offset:16
    s_add_u32 s61, s61, 1
    s_cmp_gt_u32 s61, s57
    s_cselect_b32 s62, -1, 0
    s_waitcnt lgkmcnt(0)
    v_readfirstlane_b32 s60, v16
    s_or_b32 s60, s60, s62
    s_cmp_lt_u32 s60, 1
    s_cbranch_scc1 L_wt
    buffer_load_dwordx4 v[112:115], v14, s[36:39], s80 offen offset:0 nt
    buffer_load_dwordx4 v[116:119], v14, s[36:39], s80 offen offset:896 nt
    buffer_load_dwordx4 v[120:123], v14, s[36:39], s80 offen offset:1792 nt
    buffer_load_dwordx4 v[124:127], v14, s[36:39], s80 offen offset:2688 nt
    buffer_load_dwordx4 v[128:131], v14, s[36:39], s96 offen offset:0 nt
    buffer_load_dwordx4 v[132:135], v14, s[36:39], s96 offen offset:896 nt
    buffer_load_dwordx4 v[136:139], v14, s[36:39], s96 offen offset:1792 nt
    buffer_load_dwordx4 v[140:143], v14, s[36:39], s96 offen offset:2688 nt
    s_waitcnt vmcnt(6)
    v_perm_b32 v32, v116, v112, s52
    v_perm_b32 v36, v116, v112, s53
    v_perm_b32 v40, v117, v113, s52
    v_perm_b32 v44, v117, v113, s53
    v_perm_b32 v48, v118, v114, s52
    v_perm_b32 v52, v118, v114, s53
    v_perm_b32 v56, v119, v115, s52
    v_perm_b32 v60, v119, v115, s53
    s_waitcnt vmcnt(4)
    v_perm_b32 v33, v124, v120, s52
    v_perm_b32 v37, v124, v120, s53
    v_perm_b32 v41, v125, v121, s52
    v_perm_b32 v45, v125, v121, s53
    v_perm_b32 v49, v126, v122, s52
    v_perm_b32 v53, v126, v122, s53
    v_perm_b32 v57, v127, v123, s52
    v_perm_b32 v61, v127, v123, s53
    s_waitcnt vmcnt(2)
    v_perm_b32 v34, v132, v128, s52
    v_perm_b32 v38, v132, v128, s53
    v_perm_b32 v42, v133, v129, s52
    v_perm_b32 v46, v133, v129, s53
    v_perm_b32 v50, v134, v130, s52
    v_perm_b32 v54, v134, v130, s53
    v_perm_b32 v58, v135, v131, s52
    v_perm_b32 v62, v135, v131, s53
    s_waitcnt vmcnt(0)
    v_perm_b32 v35, v140, v136, s52
    v_perm_b32 v39, v140, v136, s53
    v_perm_b32 v43, v141, v137, s52
    v_perm_b32 v47, v141, v137, s53
    v_perm_b32 v51, v142, v138, s52
    v_perm_b32 v55, v142, v138, s53
    v_perm_b32 v59, v143, v139, s52
    v_perm_b32 v63, v143, v139, s53
    s_barrier
    ds_read_b128 v[24:27], v17 offset:1920
    s_waitcnt lgkmcnt(0)
    v_mfma_f32_16x16x32_bf16 v[64:67], v[24:27], v[32:35], 0
    v_mfma_f32_16x16x32_bf16 v[80:83], v[24:27], v[48:51], 0
    v_mfma_f32_16x16x32_bf16 v[68:71], v[24:27], v[36:39], 0
    v_mfma_f32_16x16x32_bf16 v[84:87], v[24:27], v[52:55], 0
    v_mfma_f32_16x16x32_bf16 v[72:75], v[24:27], v[40:43], 0
    v_mfma_f32_16x16x32_bf16 v[88:91], v[24:27], v[56:59], 0
    v_mfma_f32_16x16x32_bf16 v[76:79], v[24:27], v[44:47], 0
    v_mfma_f32_16x16x32_bf16 v[92:95], v[24:27], v[60:63], 0
    s_mov_b64 exec, 0xffff
    v_add_f32_dpp v28, v65, v64 row_ror:8 row_mask:0xf bank_mask:0x3
    s_nop 0
    v_add_f32_dpp v29, v69, v68 row_ror:8 row_mask:0xf bank_mask:0x3
    s_nop 0
    v_add_f32_dpp v30, v73, v72 row_ror:8 row_mask:0xf bank_mask:0x3
    s_nop 0
    v_add_f32_dpp v31, v77, v76 row_ror:8 row_mask:0xf bank_mask:0x3
    v_add_f32_dpp v28, v80, v81 row_ror:8 row_mask:0xf bank_mask:0xc
    v_add_f32_dpp v29, v84, v85 row_ror:8 row_mask:0xf bank_mask:0xc
    v_add_f32_dpp v30, v88, v89 row_ror:8 row_mask:0xf bank_mask:0xc
    v_add_f32_dpp v31, v92, v93 row_ror:8 row_mask:0xf bank_mask:0xc
    v_bfi_b32 v28, v3, s30, v28
    v_bfi_b32 v29, v3, s30, v29
    v_bfi_b32 v30, v3, s31, v30
    v_bfi_b32 v31, v3, s31, v31
    buffer_store_dwordx4 v[28:31], v159, s[44:47], s54 offen sc1
    s_endpgm
L_g9:
    s_cmp_gt_u32 s3, 9
    s_cbranch_scc1 L_end
    s_lshl_b32 s51, s48, 8
    s_add_u32 s51, s51, 65536
    s_waitcnt lgkmcnt(0)
    s_load_dword s96, s[26:27], 0
    s_add_u32 s80, s26, s51
    s_addc_u32 s81, s27, 0
    s_load_dword s82, s[80:81], 0
    s_load_dword s82, s[80:81], 64
    s_load_dword s82, s[80:81], 128
    s_load_dword s82, s[80:81], 192
    s_movk_i32 s58, 0xfff
    s_mov_b32 s57, 1000000
    s_barrier
    s_cmp_eq_u32 s29, 3
    s_cbranch_scc1 L_g1
    s_mul_i32 s52, s28, 7
    s_add_u32 s52, s52, s29
    s_cmp_gt_u32 s29, 3
    s_subb_u32 s52, s52, 0
    s_lshl_b32 s52, s52, 8
    s_add_u32 s52, s52, 196608
    s_add_u32 s98, s26, s52
    s_addc_u32 s99, s27, 0
    v_lshlrev_b32 v8, 4, v0
    v_mov_b32 v9, 1
    v_mov_b32 v10, 2048
    s_movk_i32 s52, 0xff
    s_mov_b64 exec, 0xffff
    s_mov_b32 s61, 0
    s_waitcnt lgkmcnt(0)
    s_add_u32 s96, s96, 0x10001
    s_lshr_b32 s97, s96, 16
L_px:
    s_load_dwordx16 s[4:19], s[98:99], 0 glc
    s_load_dwordx16 s[20:35], s[98:99], 64 glc
    s_load_dwordx16 s[36:51], s[98:99], 128 glc
    s_load_dwordx16 s[80:95], s[98:99], 192 glc
    s_add_u32 s61, s61, 1
    s_cmp_gt_u32 s61, s57
    s_cselect_b32 s63, 0, s52
    s_waitcnt lgkmcnt(0)
    s_xor_b32 s60, s4, s96
    s_and_b32 s60, s60, s63
    s_cbranch_scc1 L_px
    v_writelane_b32 v60, s4, 0
    v_writelane_b32 v61, s5, 0
    v_writelane_b32 v62, s6, 0
    v_writelane_b32 v63, s7, 0
    v_writelane_b32 v60, s8, 1
    v_writelane_b32 v61, s9, 1
    v_writelane_b32 v62, s10, 1
    v_writelane_b32 v63, s11, 1
    v_writelane_b32 v60, s12, 2
    v_writelane_b32 v61, s13, 2
    v_writelane_b32 v62, s14, 2
    v_writelane_b32 v63, s15, 2
    v_writelane_b32 v60, s16, 3
    v_writelane_b32 v61, s17, 3
    v_writelane_b32 v62, s18, 3
    v_writelane_b32 v63, s19, 3
    v_writelane_b32 v60, s20, 4
    v_writelane_b32 v61, s21, 4
    v_writelane_b32 v62, s22, 4
    v_writelane_b32 v63, s23, 4
    v_writelane_b32 v60, s24, 5
    v_writelane_b32 v61, s25, 5
    v_writelane_b32 v62, s26, 5
    v_writelane_b32 v63, s27, 5
    v_writelane_b32 v60, s28, 6
    v_writelane_b32 v61, s29, 6
    v_writelane_b32 v62, s30, 6
    v_writelane_b32 v63, s31, 6
    v_writelane_b32 v60, s32, 7
    v_writelane_b32 v61, s33, 7
    v_writelane_b32 v62, s34, 7
    v_writelane_b32 v63, s35, 7
    v_writelane_b32 v60, s36, 8
    v_writelane_b32 v61, s37, 8
    v_writelane_b32 v62, s38, 8
    v_writelane_b32 v63, s39, 8
    v_writelane_b32 v60, s40, 9
    v_writelane_b32 v61, s41, 9
    v_writelane_b32 v62, s42, 9
    v_writelane_b32 v63, s43, 9
    v_writelane_b32 v60, s44, 10
    v_writelane_b32 v61, s45, 10
    v_writelane_b32 v62, s46, 10
    v_writelane_b32 v63, s47, 10
    v_writelane_b32 v60, s48, 11
    v_writelane_b32 v61, s49, 11
    v_writelane_b32 v62, s50, 11
    v_writelane_b32 v63, s51, 11
    v_writelane_b32 v60, s80, 12
    v_writelane_b32 v61, s81, 12
    v_writelane_b32 v62, s82, 12
    v_writelane_b32 v63, s83, 12
    v_writelane_b32 v60, s84, 13
    v_writelane_b32 v61, s85, 13
    v_writelane_b32 v62, s86, 13
    v_writelane_b32 v63, s87, 13
    v_writelane_b32 v60, s88, 14
    v_writelane_b32 v61, s89, 14
    v_writelane_b32 v62, s90, 14
    v_writelane_b32 v63, s91, 14
    v_writelane_b32 v60, s92, 15
    v_writelane_b32 v61, s93, 15
    v_writelane_b32 v62, s94, 15
    v_writelane_b32 v63, s95, 15
    v_bitop3_b32 v44, v60, v61, s96 bitop3:0x7e
    v_bitop3_b32 v45, v62, v63, s97 bitop3:0x7e
    v_bitop3_b32 v44, v44, v45, s63 bitop3:0xa8
    v_cmp_ne_u32 vcc, 0, v44
    s_cbranch_vccnz L_px
    ds_write_b128 v8, v[60:63] offset:2304
    ds_write_b32 v10, v9 offset:12
    s_mov_b64 exec, -1
    s_load_dwordx2 s[26:27], s[0:1], 88
    s_and_b32 s28, s2, 7
    s_lshr_b32 s29, s2, 3
    s_lshl3_add_u32 s48, s28, s29
    s_waitcnt lgkmcnt(0)
    s_branch L_g2
L_g:
    s_waitcnt lgkmcnt(0)
    s_barrier
L_g1:
    s_cmp_eq_u32 s29, 3
    s_cselect_b32 s62, 0, 12
    s_cselect_b32 s63, 7, 1
    v_mov_b32 v50, s62
    s_mov_b32 s61, 0
L_gw:
    s_sleep 2
    ds_read_b32 v51, v50 offset:2048
    s_add_u32 s61, s61, 1
    s_cmp_gt_u32 s61, s57
    s_cselect_b32 s62, -1, 0
    s_waitcnt lgkmcnt(0)
    v_readfirstlane_b32 s60, v51
    s_or_b32 s60, s60, s62
    s_cmp_lt_u32 s60, s63
    s_cbranch_scc1 L_gw
L_g2:
    s_mov_b32 s44, s26
    s_mov_b32 s45, s27
    s_mov_b32 s46, 536870912
    s_mov_b32 s47, 0x20000
    s_load_dword s30, s[26:27], 0
    v_lshrrev_b32 v2, 4, v0
    v_lshrrev_b32 v8, 3, v0
    v_and_b32 v9, 7, v0
    v_lshlrev_b32 v10, 4, v9
    v_lshl_add_u32 v10, v8, 11, v10
    v_add_u32 v11, 16384, v10
    v_add_u32 v12, 32768, v10
    v_lshlrev_b32 v13, 4, v8
    s_lshr_b32 s51, s48, 2
    s_lshl_b32 s51, s51, 9
    s_add_u32 s51, s51, 131072
    s_mul_i32 s53, s28, 49152
    s_lshl_b32 s52, s29, 8
    s_add_u32 s53, s53, s52
    s_and_b32 s50, s3, 1
    s_lshl_b32 s52, s50, 7
    s_add_u32 s53, s53, s52
    s_add_u32 s53, s53, 262144
    s_mov_b32 s55, 0x3db8aa3b
    v_mov_b32 v3, 0xfff
    s_movk_i32 s54, 0x800
    v_lshlrev_b32 v14, 3, v9
    v_lshl_add_u32 v14, v2, 1, v14
    s_lshl_b32 s52, s50, 6
    v_add_u32 v14, s52, v14
    v_mov_b32 v50, 2048
    v_mov_b32 v51, 1
    s_waitcnt lgkmcnt(0)
    s_add_u32 s30, s30, 0x10001
    s_lshr_b32 s31, s30, 16
    s_mov_b32 s61, 0
    s_mov_b32 s60, s51
    s_add_u32 s62, s51, 1048576
L_pst:
    buffer_load_dwordx4 v[16:19], v13, s[44:47], s60 offen sc1
    buffer_load_dwordx4 v[20:23], v13, s[44:47], s60 offen offset:128 sc1
    buffer_load_dwordx4 v[24:27], v13, s[44:47], s60 offen offset:256 sc1
    s_add_u32 s61, s61, 1
    s_and_b32 s63, s61, 15
    s_cmp_eq_u32 s63, 15
    s_cselect_b32 s60, s62, s51
    s_cmp_gt_u32 s61, s57
    s_cselect_b32 s63, 0, s58
    s_waitcnt vmcnt(0)
    v_bitop3_b32 v44, v16, v17, s30 bitop3:0x7e
    v_bitop3_b32 v45, v18, v19, s31 bitop3:0x7e
    v_bitop3_b32 v46, v20, v21, s30 bitop3:0x7e
    v_bitop3_b32 v47, v22, v23, s31 bitop3:0x7e
    v_bitop3_b32 v48, v24, v25, s30 bitop3:0x7e
    v_bitop3_b32 v49, v26, v27, s31 bitop3:0x7e
    v_or3_b32 v44, v44, v46, v47
    v_or3_b32 v45, v45, v48, v49
    v_bitop3_b32 v44, v44, v45, s63 bitop3:0xa8
    v_cmp_ne_u32 vcc, 0, v44
    s_and_b64 exec, exec, vcc
    s_cbranch_execnz L_pst
    s_mov_b64 exec, -1
    ds_write_b32 v50, v51 offset:16
    s_setprio 3
    v_bfi_b32 v16, v3, 0, v16
    v_bfi_b32 v17, v3, s54, v17
    v_bfi_b32 v20, v3, 0, v20
    v_bfi_b32 v21, v3, s54, v21
    v_bfi_b32 v24, v3, 0, v24
    v_bfi_b32 v25, v3, s54, v25
    v_max3_f32 v28, v16, v20, v24
    s_nop 1
    v_max_f32_dpp v28, v28, v28 row_ror:8 row_mask:0xf bank_mask:0xf
    v_mov_b32 v29, v28
    s_nop 1
    v_permlane16_swap_b32 v28, v29
    v_max_f32 v28, v28, v29
    v_mov_b32 v29, v28
    s_nop 1
    v_permlane32_swap_b32 v28, v29
    v_max_f32 v28, v28, v29
    v_sub_f32 v16, v16, v28
    v_sub_f32 v20, v20, v28
    v_sub_f32 v24, v24, v28
    v_mul_f32 v16, s55, v16
    v_mul_f32 v20, s55, v20
    v_mul_f32 v24, s55, v24
    v_exp_f32 v16, v16
    v_exp_f32 v20, v20
    v_exp_f32 v24, v24
    v_mul_f32 v28, v16, v17
    v_fmac_f32 v28, v20, v21
    v_fmac_f32 v28, v24, v25
    s_nop 1
    v_add_f32_dpp v28, v28, v28 row_ror:8 row_mask:0xf bank_mask:0xf
    v_mov_b32 v29, v28
    s_nop 1
    v_permlane16_swap_b32 v28, v29
    v_add_f32 v28, v28, v29
    v_mov_b32 v29, v28
    s_nop 1
    v_permlane32_swap_b32 v28, v29
    v_add_f32 v28, v28, v29
    v_rcp_f32 v28, v28
    s_nop 0
    v_mul_f32 v16, v16, v28
    v_mul_f32 v20, v20, v28
    v_mul_f32 v24, v24, v28
    s_mov_b32 s61, 0
    s_mov_b32 s60, s53
    s_add_u32 s62, s53, 1048576
L_po:
    buffer_load_dwordx4 v[32:35], v10, s[44:47], s60 offen sc1
    buffer_load_dwordx4 v[36:39], v11, s[44:47], s60 offen sc1
    buffer_load_dwordx4 v[40:43], v12, s[44:47], s60 offen sc1
    s_add_u32 s61, s61, 1
    s_and_b32 s63, s61, 15
    s_cmp_eq_u32 s63, 15
    s_cselect_b32 s60, s62, s53
    s_cmp_gt_u32 s61, s57
    s_cselect_b32 s63, 0, s58
    s_waitcnt vmcnt(0)
    v_bitop3_b32 v44, v32, v33, s30 bitop3:0x7e
    v_bitop3_b32 v45, v34, v35, s31 bitop3:0x7e
    v_bitop3_b32 v46, v36, v37, s30 bitop3:0x7e
    v_bitop3_b32 v47, v38, v39, s31 bitop3:0x7e
    v_bitop3_b32 v48, v40, v41, s30 bitop3:0x7e
    v_bitop3_b32 v49, v42, v43, s31 bitop3:0x7e
    v_or3_b32 v44, v44, v46, v47
    v_or3_b32 v45, v45, v48, v49
    v_bitop3_b32 v44, v44, v45, s63 bitop3:0xa8
    v_cmp_ne_u32 vcc, 0, v44
    s_and_b64 exec, exec, vcc
    s_cbranch_execnz L_po
    s_mov_b64 exec, -1
    v_bfi_b32 v32, v3, s54, v32
    v_bfi_b32 v33, v3, s54, v33
    v_bfi_b32 v34, v3, s54, v34
    v_bfi_b32 v35, v3, s54, v35
    v_bfi_b32 v36, v3, s54, v36
    v_bfi_b32 v37, v3, s54, v37
    v_bfi_b32 v38, v3, s54, v38
    v_bfi_b32 v39, v3, s54, v39
    v_bfi_b32 v40, v3, s54, v40
    v_bfi_b32 v41, v3, s54, v41
    v_bfi_b32 v42, v3, s54, v42
    v_bfi_b32 v43, v3, s54, v43
    v_pk_mul_f32 v[32:33], v[32:33], v[16:17] op_sel:[0,0] op_sel_hi:[1,0]
    v_pk_mul_f32 v[34:35], v[34:35], v[16:17] op_sel:[0,0] op_sel_hi:[1,0]
    v_pk_fma_f32 v[32:33], v[36:37], v[20:21], v[32:33] op_sel:[0,0,0] op_sel_hi:[1,0,1]
    v_pk_fma_f32 v[34:35], v[38:39], v[20:21], v[34:35] op_sel:[0,0,0] op_sel_hi:[1,0,1]
    v_pk_fma_f32 v[32:33], v[40:41], v[24:25], v[32:33] op_sel:[0,0,0] op_sel_hi:[1,0,1]
    v_pk_fma_f32 v[34:35], v[42:43], v[24:25], v[34:35] op_sel:[0,0,0] op_sel_hi:[1,0,1]
    s_nop 1
    v_permlane32_swap_b32 v32, v34
    v_permlane32_swap_b32 v33, v35
    v_add_f32 v32, v32, v34
    v_add_f32 v33, v33, v35
    s_nop 1
    v_permlane16_swap_b32 v32, v33
    v_add_f32 v32, v32, v33
    s_nop 1
    v_add_f32_dpp v32, v32, v32 row_ror:8 row_mask:0xf bank_mask:0xf
    v_cvt_pk_bf16_f32 v32, v32, v32
    ds_write_b16 v14, v32 offset:1920
    s_waitcnt lgkmcnt(0)
    s_barrier
    s_endpgm
L_w7:
    s_setprio 2
    v_mov_b32 v9, 2048
    v_lshlrev_b32 v17, 4, v1
    v_lshl_add_u32 v17, v2, 8, v17
    s_lshl_b32 s51, s48, 8
    s_add_u32 s51, s51, 65536
    s_add_u32 s52, s51, 1048576
    s_and_b32 s53, s30, 0xffff
    v_cmp_gt_u32 vcc, 32, v0
    s_mov_b32 s61, 0
L_wq:
    ds_read_b32 v16, v9 offset:0
    s_add_u32 s61, s61, 1
    s_cmp_gt_u32 s61, s57
    s_cselect_b32 s62, -1, 0
    s_waitcnt lgkmcnt(0)
    v_readfirstlane_b32 s60, v16
    s_or_b32 s60, s60, s62
    s_cmp_lt_u32 s60, 7
    s_cbranch_scc1 L_wq
    ds_read_b128 v[32:35], v17 offset:4096
    ds_read_b128 v[36:39], v17 offset:5120
    ds_read_b128 v[40:43], v17 offset:6144
    ds_read_b128 v[44:47], v17 offset:7168
    s_waitcnt lgkmcnt(0)
    v_cndmask_b32 v44, 0, v44, vcc
    v_cndmask_b32 v45, 0, v45, vcc
    v_cndmask_b32 v46, 0, v46, vcc
    v_cndmask_b32 v47, 0, v47, vcc
    v_pk_add_f32 v[32:33], v[32:33], v[36:37]
    v_pk_add_f32 v[34:35], v[34:35], v[38:39]
    v_pk_add_f32 v[32:33], v[32:33], v[40:41]
    v_pk_add_f32 v[34:35], v[34:35], v[42:43]
    v_pk_add_f32 v[32:33], v[32:33], v[44:45]
    v_pk_add_f32 v[34:35], v[34:35], v[46:47]
    v_mov_b32 v36, v32
    v_mov_b32 v37, v33
    v_mov_b32 v38, v34
    v_mov_b32 v39, v35
    v_permlane16_swap_b32 v32, v36
    v_permlane16_swap_b32 v33, v37
    v_permlane16_swap_b32 v34, v38
    v_permlane16_swap_b32 v35, v39
    v_add_f32 v32, v32, v36
    v_add_f32 v33, v33, v37
    v_add_f32 v34, v34, v38
    v_add_f32 v35, v35, v39
    v_mov_b32 v36, v32
    v_mov_b32 v37, v33
    v_mov_b32 v38, v34
    v_mov_b32 v39, v35
    v_permlane32_swap_b32 v32, v36
    v_permlane32_swap_b32 v33, v37
    v_permlane32_swap_b32 v34, v38
    v_permlane32_swap_b32 v35, v39
    v_add_f32 v32, v32, v36
    v_add_f32 v33, v33, v37
    v_add_f32 v34, v34, v38
    v_add_f32 v35, v35, v39
    v_cvt_pk_bf16_f32 v32, 0, v32
    v_cvt_pk_bf16_f32 v33, 0, v33
    v_cvt_pk_bf16_f32 v34, 0, v34
    v_cvt_pk_bf16_f32 v35, 0, v35
    v_or_b32 v32, s53, v32
    v_or_b32 v33, s53, v33
    v_or_b32 v34, s31, v34
    v_or_b32 v35, s31, v35
    s_mov_b64 exec, 0xffff
    buffer_store_dwordx4 v[32:35], v159, s[44:47], s51 offen
    buffer_store_dwordx4 v[32:35], v159, s[44:47], s52 offen sc1
    s_mov_b64 exec, -1
    s_cmp_eq_u32 s56, 0
    s_cbranch_scc1 L_w7_end
    s_and_b32 s54, s49, 1
    s_lshl_b32 s54, s54, 6
    v_and_b32 v17, 31, v0
    v_lshlrev_b32 v17, 4, v17
    v_xor_b32 v17, s54, v17
    v_lshrrev_b32 v18, 5, v0
    v_mul_u32_u24 v18, 3584, v18
    v_add_u32 v17, v17, v18
    v_and_b32 v18, 0x18, v0
    v_lshlrev_b32 v18, 3, v18
    v_and_b32 v19, 3, v0
    v_lshl_add_u32 v18, v19, 4, v18
    v_lshlrev_b32 v19, 5, v19
    v_and_b32 v20, 8, v0
    v_lshl_add_u32 v19, v20, 1, v19
    s_xor_b32 s51, s49, 1
    s_lshl_b32 s51, s51, 8
    s_add_u32 s51, s51, 196608
    v_mov_b32 v3, 0xff
    s_mov_b32 s61, 0
L_wg:
    ds_read_b32 v16, v9 offset:4
    s_add_u32 s61, s61, 1
    s_cmp_gt_u32 s61, s57
    s_cselect_b32 s62, -1, 0
    s_waitcnt lgkmcnt(0)
    v_readfirstlane_b32 s60, v16
    s_or_b32 s60, s60, s62
    s_cmp_lt_u32 s60, 7
    s_cbranch_scc1 L_wg
    ds_read_b128 v[32:35], v17 offset:8192
    ds_read_b128 v[36:39], v17 offset:8704
    ds_read_b128 v[40:43], v17 offset:9216
    ds_read_b128 v[44:47], v17 offset:9728
    ds_read_b128 v[48:51], v17 offset:10240
    ds_read_b128 v[52:55], v17 offset:10752
    ds_read_b128 v[56:59], v17 offset:11264
    s_waitcnt lgkmcnt(0)
    v_pk_add_f32 v[32:33], v[32:33], v[36:37]
    v_pk_add_f32 v[34:35], v[34:35], v[38:39]
    v_pk_add_f32 v[32:33], v[32:33], v[40:41]
    v_pk_add_f32 v[34:35], v[34:35], v[42:43]
    v_pk_add_f32 v[32:33], v[32:33], v[44:45]
    v_pk_add_f32 v[34:35], v[34:35], v[46:47]
    v_pk_add_f32 v[32:33], v[32:33], v[48:49]
    v_pk_add_f32 v[34:35], v[34:35], v[50:51]
    v_pk_add_f32 v[32:33], v[32:33], v[52:53]
    v_pk_add_f32 v[34:35], v[34:35], v[54:55]
    v_pk_add_f32 v[32:33], v[32:33], v[56:57]
    v_pk_add_f32 v[34:35], v[34:35], v[58:59]
    v_mov_b32 v36, v32
    v_mov_b32 v37, v33
    v_mov_b32 v38, v34
    v_mov_b32 v39, v35
    v_permlane32_swap_b32 v32, v36
    v_permlane32_swap_b32 v33, v37
    v_permlane32_swap_b32 v34, v38
    v_permlane32_swap_b32 v35, v39
    v_add_f32 v32, v32, v36
    v_add_f32 v33, v33, v37
    v_add_f32 v34, v34, v38
    v_add_f32 v35, v35, v39
    v_bfi_b32 v36, v3, s30, v32
    v_bfi_b32 v37, v3, s30, v33
    v_bfi_b32 v38, v3, s31, v34
    v_bfi_b32 v39, v3, s31, v35
    s_mov_b32 exec_lo, 0xf0f0f0f0
    s_mov_b32 exec_hi, 0x0
    buffer_store_dwordx4 v[36:39], v18, s[44:47], s51 offen sc1
    s_mov_b64 exec, -1
    s_mov_b32 s61, 0
L_wx:
    ds_read_b32 v16, v9 offset:12
    s_add_u32 s61, s61, 1
    s_cmp_gt_u32 s61, s57
    s_cselect_b32 s62, -1, 0
    s_waitcnt lgkmcnt(0)
    v_readfirstlane_b32 s60, v16
    s_or_b32 s60, s60, s62
    s_cmp_lt_u32 s60, 1
    s_cbranch_scc1 L_wx
    ds_read_b128 v[60:63], v18 offset:2304
    s_movk_i32 s55, 0x80
    s_waitcnt lgkmcnt(0)
    v_bfi_b32 v60, v3, s55, v60
    v_bfi_b32 v61, v3, s55, v61
    v_bfi_b32 v62, v3, s55, v62
    v_bfi_b32 v63, v3, s55, v63
    v_add_f32 v32, v32, v60
    v_add_f32 v33, v33, v61
    v_add_f32 v34, v34, v62
    v_add_f32 v35, v35, v63
    v_cvt_pk_bf16_f32 v32, 0, v32
    v_cvt_pk_bf16_f32 v33, 0, v33
    v_cvt_pk_bf16_f32 v34, 0, v34
    v_cvt_pk_bf16_f32 v35, 0, v35
    v_mov_b32 v40, v32
    v_mov_b32 v41, v33
    v_mov_b32 v42, v34
    v_mov_b32 v43, v35
    v_permlane16_swap_b32 v32, v40
    v_permlane16_swap_b32 v33, v41
    v_permlane16_swap_b32 v34, v42
    v_permlane16_swap_b32 v35, v43
    s_mov_b32 s51, 0xbdd2d3e8
    v_mov_b32 v48, 0xc0135761
    v_mul_f32 v44, v32, v32
    v_mul_f32 v45, v33, v33
    v_mul_f32 v46, v34, v34
    v_mul_f32 v47, v35, v35
    v_fma_f32 v44, v44, s51, v48
    v_fma_f32 v45, v45, s51, v48
    v_fma_f32 v46, v46, s51, v48
    v_fma_f32 v47, v47, s51, v48
    v_mul_f32 v44, v44, v32
    v_mul_f32 v45, v45, v33
    v_mul_f32 v46, v46, v34
    v_mul_f32 v47, v47, v35
    v_exp_f32 v44, v44
    v_exp_f32 v45, v45
    v_exp_f32 v46, v46
    v_exp_f32 v47, v47
    v_add_f32 v44, 1.0, v44
    v_add_f32 v45, 1.0, v45
    v_add_f32 v46, 1.0, v46
    v_add_f32 v47, 1.0, v47
    v_rcp_f32 v44, v44
    v_rcp_f32 v45, v45
    v_rcp_f32 v46, v46
    v_rcp_f32 v47, v47
    v_mul_f32 v44, v44, v32
    v_mul_f32 v45, v45, v33
    v_mul_f32 v46, v46, v34
    v_mul_f32 v47, v47, v35
    v_cvt_pk_bf16_f32 v44, 0, v44
    v_cvt_pk_bf16_f32 v45, 0, v45
    v_cvt_pk_bf16_f32 v46, 0, v46
    v_cvt_pk_bf16_f32 v47, 0, v47
    v_mul_f32 v44, v44, v40
    v_mul_f32 v45, v45, v41
    v_mul_f32 v46, v46, v42
    v_mul_f32 v47, v47, v43
    v_cvt_pk_bf16_f32 v44, v44, v44
    v_cvt_pk_bf16_f32 v45, v45, v45
    v_cvt_pk_bf16_f32 v46, v46, v46
    v_cvt_pk_bf16_f32 v47, v47, v47
    s_mov_b64 exec, 0x0f0f
    ds_write_b128 v19, v[44:47] offset:1792
    v_mov_b32 v8, 1
    ds_write_b32 v9, v8 offset:8
    s_mov_b64 exec, -1
L_w7_end:
    s_waitcnt lgkmcnt(0)
    s_endpgm
L_ln:
    s_mov_b32 s3, 8
    s_movk_i32 s58, 0xfff
    s_mov_b32 s57, 1000000
    s_mov_b32 s52, 0xffff0000
    s_mov_b32 s53, 0x3b124925
    v_cmp_gt_u32 vcc, 56, v0
    v_lshlrev_b32 v8, 5, v0
    v_lshlrev_b32 v9, 2, v0
    v_mov_b32 v10, 0
    ds_write_b32 v9, v10 offset:2048
    s_waitcnt vmcnt(0)
    v_lshlrev_b32 v20, 16, v16
    v_and_b32 v21, s52, v16
    v_lshlrev_b32 v22, 16, v17
    v_and_b32 v23, s52, v17
    v_lshlrev_b32 v24, 16, v18
    v_and_b32 v25, s52, v18
    v_lshlrev_b32 v26, 16, v19
    v_and_b32 v27, s52, v19
    v_add_f32 v28, v20, v21
    v_add_f32 v28, v28, v22
    v_add_f32 v28, v28, v23
    v_add_f32 v28, v28, v24
    v_add_f32 v28, v28, v25
    v_add_f32 v28, v28, v26
    v_add_f32 v28, v28, v27
    s_nop 1
    v_add_f32_dpp v28, v28, v28 row_ror:8 row_mask:0xf bank_mask:0xf
    s_nop 1
    v_add_f32_dpp v28, v28, v28 row_ror:4 row_mask:0xf bank_mask:0xf
    s_nop 1
    v_add_f32_dpp v28, v28, v28 row_ror:2 row_mask:0xf bank_mask:0xf
    s_nop 1
    v_add_f32_dpp v28, v28, v28 row_ror:1 row_mask:0xf bank_mask:0xf
    v_mov_b32 v29, v28
    s_nop 1
    v_permlane16_swap_b32 v28, v29
    v_add_f32 v28, v28, v29
    v_mov_b32 v29, v28
    s_nop 1
    v_permlane32_swap_b32 v28, v29
    v_add_f32 v28, v28, v29
    v_mul_f32 v28, s53, v28
    v_sub_f32 v32, v20, v28
    v_sub_f32 v33, v21, v28
    v_sub_f32 v34, v22, v28
    v_sub_f32 v35, v23, v28
    v_sub_f32 v36, v24, v28
    v_sub_f32 v37, v25, v28
    v_sub_f32 v38, v26, v28
    v_sub_f32 v39, v27, v28
    v_mul_f32 v30, v32, v32
    v_fmac_f32 v30, v33, v33
    v_fmac_f32 v30, v34, v34
    v_fmac_f32 v30, v35, v35
    v_fmac_f32 v30, v36, v36
    v_fmac_f32 v30, v37, v37
    v_fmac_f32 v30, v38, v38
    v_fmac_f32 v30, v39, v39
    v_cndmask_b32 v30, 0, v30, vcc
    s_nop 1
    v_add_f32_dpp v30, v30, v30 row_ror:8 row_mask:0xf bank_mask:0xf
    s_nop 1
    v_add_f32_dpp v30, v30, v30 row_ror:4 row_mask:0xf bank_mask:0xf
    s_nop 1
    v_add_f32_dpp v30, v30, v30 row_ror:2 row_mask:0xf bank_mask:0xf
    s_nop 1
    v_add_f32_dpp v30, v30, v30 row_ror:1 row_mask:0xf bank_mask:0xf
    v_mov_b32 v29, v30
    s_nop 1
    v_permlane16_swap_b32 v30, v29
    v_add_f32 v30, v30, v29
    v_mov_b32 v29, v30
    s_nop 1
    v_permlane32_swap_b32 v30, v29
    v_add_f32 v30, v30, v29
    v_mul_f32 v30, s53, v30
    v_cvt_pk_bf16_f32 v30, 0, v30
    v_add_f32 v30, 0x3727c5ac, v30
    v_cvt_pk_bf16_f32 v30, 0, v30
    v_sqrt_f32 v30, v30
    s_nop 0
    v_cvt_pk_bf16_f32 v30, 0, v30
    v_rcp_f32 v31, v30
    v_cvt_pk_bf16_f32 v28, 0, v28
    v_sub_f32 v20, v20, v28
    v_sub_f32 v21, v21, v28
    v_sub_f32 v22, v22, v28
    v_sub_f32 v23, v23, v28
    v_sub_f32 v24, v24, v28
    v_sub_f32 v25, v25, v28
    v_sub_f32 v26, v26, v28
    v_sub_f32 v27, v27, v28
    v_cvt_pk_bf16_f32 v20, 0, v20
    v_cvt_pk_bf16_f32 v21, 0, v21
    v_cvt_pk_bf16_f32 v22, 0, v22
    v_cvt_pk_bf16_f32 v23, 0, v23
    v_cvt_pk_bf16_f32 v24, 0, v24
    v_cvt_pk_bf16_f32 v25, 0, v25
    v_cvt_pk_bf16_f32 v26, 0, v26
    v_cvt_pk_bf16_f32 v27, 0, v27
    v_mul_f32 v32, v20, v31
    v_mul_f32 v33, v21, v31
    v_mul_f32 v34, v22, v31
    v_mul_f32 v35, v23, v31
    v_mul_f32 v36, v24, v31
    v_mul_f32 v37, v25, v31
    v_mul_f32 v38, v26, v31
    v_mul_f32 v39, v27, v31
    v_fma_f32 v20, -v32, v30, v20
    v_fma_f32 v21, -v33, v30, v21
    v_fma_f32 v22, -v34, v30, v22
    v_fma_f32 v23, -v35, v30, v23
    v_fma_f32 v24, -v36, v30, v24
    v_fma_f32 v25, -v37, v30, v25
    v_fma_f32 v26, -v38, v30, v26
    v_fma_f32 v27, -v39, v30, v27
    v_fmac_f32 v32, v20, v31
    v_fmac_f32 v33, v21, v31
    v_fmac_f32 v34, v22, v31
    v_fmac_f32 v35, v23, v31
    v_fmac_f32 v36, v24, v31
    v_fmac_f32 v37, v25, v31
    v_fmac_f32 v38, v26, v31
    v_fmac_f32 v39, v27, v31
    v_cvt_pk_bf16_f32 v32, v32, v32
    v_cvt_pk_bf16_f32 v33, v33, v33
    v_cvt_pk_bf16_f32 v34, v34, v34
    v_cvt_pk_bf16_f32 v35, v35, v35
    v_cvt_pk_bf16_f32 v36, v36, v36
    v_cvt_pk_bf16_f32 v37, v37, v37
    v_cvt_pk_bf16_f32 v38, v38, v38
    v_cvt_pk_bf16_f32 v39, v39, v39
    s_mov_b64 exec, vcc
    ds_write_b128 v8, v[32:35] offset:0
    ds_write_b128 v8, v[36:39] offset:16
    s_mov_b64 exec, -1
    s_setprio 0
    s_branch L_g
L_end:
    s_endpgm
.section .rodata,"a"
.p2align 6
.amdhsa_kernel recurrent_scan__sliding_block_cached__geglu_ffn__decode_kernel
.amdhsa_next_free_vgpr 160
.amdhsa_next_free_sgpr 100
.amdhsa_accum_offset 160
.amdhsa_group_segment_fixed_size 0
.amdhsa_kernarg_size 96
.amdhsa_user_sgpr_count 2
.amdhsa_user_sgpr_kernarg_segment_ptr 1
.amdhsa_system_sgpr_workgroup_id_x 1
.end_amdhsa_kernel
```
